```python
import torch

def _softmax(x, axis=-1):
    return torch.softmax(x, dim=axis)
def _gelu(x):
    return torch.nn.functional.gelu(x, approximate="tanh")
def _silu(x):
    return torch.nn.functional.silu(x)
def _sigmoid(x):
    return torch.sigmoid(x)
def _layernorm(x, axis=-1, eps=1e-5):
    m = x.mean(dim=axis, keepdim=True)
    v = x.var(dim=axis, keepdim=True, unbiased=False)
    return (x - m) / torch.sqrt(v + eps)
def _scatter_add(tgt, idx, src, axis=0):
    return tgt.clone().index_add_(axis, idx, src)
def _segment_sum(src, seg, n):
    out = torch.zeros((n,) + src.shape[1:], dtype=src.dtype)
    return out.index_add_(0, seg, src)
def _pad(x, pw):
    flat = tuple(v for pair in reversed(pw) for v in pair)
    return torch.nn.functional.pad(x, flat)

kernel_name = 'parallel_sum__sliding_block_cached__dense_activation_silu__decode'

def setup_inputs():

    _w = (lambda a: (lambda t: t.to(torch.bfloat16) if t.is_floating_point() else t)(torch.as_tensor(a)))
    def _A_setup():
        B, Sq, D = 1, 1, 512
        Hq, Hkv, Sk, Dh = 32, 32, 8192, 128
        assert Hq % Hkv == 0, (Hq, Hkv)
        return {
            "x": _w((lambda *s: torch.randn(*s, dtype=torch.bfloat16) * 0.05)(B, Sq, D)),
            "k_cache": _w((lambda *s: torch.randn(*s, dtype=torch.bfloat16) * 3.2)(B, Hkv, Sk, Dh)),
            "v_cache": _w((lambda *s: torch.randn(*s, dtype=torch.bfloat16) * 0.8)(B, Hkv, Sk, Dh)),
            "wq": _w((lambda *s: torch.randn(*s, dtype=torch.bfloat16) * 3.2)(D, Hq * Dh) * (D ** -0.5)),
            "wo": _w((lambda *s: torch.randn(*s, dtype=torch.bfloat16) * 0.8)(Hq * Dh, D) * ((Hq * Dh) ** -0.5)),
        }
    _A_in = _A_setup()

    def _B_setup():
        B, S, D, F = 1, 1, 512, 1376
        return {
            "x": _w((lambda *s: torch.randn(*s, dtype=torch.bfloat16) * 0.05)(B, S, D)),
            "w1": _w((lambda *s: torch.randn(*s, dtype=torch.bfloat16) * 3.2)(D, F) * (D ** -0.5)),
            "w2": _w((lambda *s: torch.randn(*s, dtype=torch.bfloat16) * 0.2)(F, D) * (F ** -0.5)),
        }
    _B_in = _B_setup()

    return {
        "A_x": _A_in["x"],
        "A_k_cache": _A_in["k_cache"],
        "A_v_cache": _A_in["v_cache"],
        "A_wq": _A_in["wq"],
        "A_wo": _A_in["wo"],
        "B_x": _B_in["x"],
        "B_w1": _B_in["w1"],
        "B_w2": _B_in["w2"],
    }

def reference(A_x, A_k_cache, A_v_cache, A_wq, A_wo, B_x, B_w1, B_w2):
    def _A_ref(x, k_cache, v_cache, wq, wo):
        B, Sq, D = x.shape
        Hq, Dh = 32, 128
        Hkv, Sk = k_cache.shape[1], k_cache.shape[2]
        W = min(4096, max(256, Sk // 4))
        rep = Hq // Hkv
        q = (lambda x, *d: x.permute(*d))((x @ wq).reshape(B, Sq, Hq, Dh), 0, 2, 1, 3)
        k = (lambda x, n, axis: torch.repeat_interleave(x, n, dim=axis))(k_cache[:, :, Sk - W:, :], rep, axis=1)
        v = (lambda x, n, axis: torch.repeat_interleave(x, n, dim=axis))(v_cache[:, :, Sk - W:, :], rep, axis=1)
        scores = torch.einsum("bhqd,bhkd->bhqk", q, k) * (Dh ** -0.5)
        p = _softmax(scores, axis=-1)
        o = torch.einsum("bhqk,bhkd->bhqd", p, v)
        return (lambda x, *d: x.permute(*d))(o, 0, 2, 1, 3).reshape(B, Sq, Hq * Dh) @ wo

    def _B_ref(x, w1, w2):
        h = torch.einsum("bsd,df->bsf", x, w1)
        h = _silu(h)
        out = torch.einsum("bsf,fd->bsd", h, w2)
        return out

    x = A_x
    xn = _layernorm(x, axis=-1)
    return x + _A_ref(xn, A_k_cache, A_v_cache, A_wq, A_wo) + _B_ref(xn, B_w1, B_w2)
```

```asm
; @launch grid=(256,1,1) block=(320,1,1) lds=7680
.amdgcn_target "amdgcn-amd-amdhsa--gfx950"
.text
.globl parallel_sum__sliding_block_cached__dense_activation_silu__decode_kernel
.p2align 8
.type parallel_sum__sliding_block_cached__dense_activation_silu__decode_kernel,@function
parallel_sum__sliding_block_cached__dense_activation_silu__decode_kernel:
s_cmp_ge_u32 s2, 256
s_cbranch_scc1 L_end
s_load_dwordx2 s[20:21], s[0:1], 8
s_load_dwordx2 s[16:17], s[0:1], 0
s_load_dwordx2 s[28:29], s[0:1], 24
v_lshrrev_b32 v22, 6, v0
v_and_b32 v1, 63, v0
v_and_b32 v2, 15, v0
v_readfirstlane_b32 s5, v22
v_lshrrev_b32 v3, 4, v1
s_and_b32 s3, s2, 7
s_lshl_b32 s3, s3, 2
s_lshr_b32 s4, s2, 6
s_add_u32 s3, s3, s4
s_bfe_u32 s4, s2, 0x30003
s_cmp_eq_u32 s5, 0
s_cbranch_scc1 L_helper
s_mov_b32 s22, 0x4000000
s_mov_b32 s23, 0x20000
s_sub_u32 s5, s5, 1
s_lshl_b32 s13, s3, 21
s_lshl_b32 s14, s4, 16
s_add_u32 s13, s13, s14
s_lshl_b32 s14, s5, 14
s_add_u32 s13, s13, s14
s_add_u32 s13, s13, 0x180000
v_lshlrev_b32 v23, 4, v1
v_add_u32 v8, s13, v23
s_lshl_b32 s53, s5, 2
s_add_u32 s53, s53, s3
s_and_b32 s53, s53, 15
s_lshl_b32 s53, s53, 10
s_waitcnt lgkmcnt(0)
buffer_load_dwordx4 v[64:67], v8, s[20:23], s53 offen nt
s_add_u32 s53, s53, 0x400
s_and_b32 s53, s53, 0x3fff
buffer_load_dwordx4 v[68:71], v8, s[20:23], s53 offen nt
s_add_u32 s53, s53, 0x400
s_and_b32 s53, s53, 0x3fff
buffer_load_dwordx4 v[72:75], v8, s[20:23], s53 offen nt
s_add_u32 s53, s53, 0x400
s_and_b32 s53, s53, 0x3fff
buffer_load_dwordx4 v[76:79], v8, s[20:23], s53 offen nt
s_add_u32 s53, s53, 0x400
s_and_b32 s53, s53, 0x3fff
s_load_dwordx2 s[24:25], s[0:1], 16
s_load_dwordx2 s[32:33], s[0:1], 32
s_load_dwordx2 s[40:41], s[0:1], 56
s_barrier
buffer_load_dwordx4 v[80:83], v8, s[20:23], s53 offen nt
s_add_u32 s53, s53, 0x400
s_and_b32 s53, s53, 0x3fff
buffer_load_dwordx4 v[84:87], v8, s[20:23], s53 offen nt
s_add_u32 s53, s53, 0x400
s_and_b32 s53, s53, 0x3fff
buffer_load_dwordx4 v[88:91], v8, s[20:23], s53 offen nt
s_add_u32 s53, s53, 0x400
s_and_b32 s53, s53, 0x3fff
s_branch L_streamer
L_helper:
s_setprio 3
s_load_dwordx2 s[36:37], s[0:1], 48
s_load_dwordx2 s[48:49], s[0:1], 80
s_load_dwordx2 s[44:45], s[0:1], 64
s_mov_b32 s18, 0x400
s_mov_b32 s19, 0x20000
s_mov_b32 s30, 0x400000
s_mov_b32 s31, 0x20000
v_lshlrev_b32 v21, 4, v1
v_lshlrev_b32 v20, 1, v1
s_lshl_b32 s12, s4, 7
v_add_u32 v20, s12, v20
v_lshlrev_b32 v22, 13, v3
v_lshlrev_b32 v23, 4, v2
v_add_u32 v22, v22, v23
s_lshl_b32 s13, s4, 19
s_lshl_b32 s14, s3, 8
s_add_u32 s13, s13, s14
v_add_u32 v22, s13, v22
s_waitcnt lgkmcnt(0)
buffer_load_dwordx4 v[16:19], v21, s[16:19], 0 offen
buffer_load_ushort v8, v20, s[16:19], 0 offen
s_load_dword s6, s[48:49], 0
s_mov_b32 s13, 0
buffer_load_dwordx4 v[32:35], v22, s[28:31], s13 offen nt
s_add_u32 s13, s13, 0x8000
buffer_load_dwordx4 v[36:39], v22, s[28:31], s13 offen nt
s_add_u32 s13, s13, 0x8000
buffer_load_dwordx4 v[40:43], v22, s[28:31], s13 offen nt
s_add_u32 s13, s13, 0x8000
buffer_load_dwordx4 v[44:47], v22, s[28:31], s13 offen nt
s_add_u32 s13, s13, 0x8000
buffer_load_dwordx4 v[48:51], v22, s[28:31], s13 offen nt
s_add_u32 s13, s13, 0x8000
buffer_load_dwordx4 v[52:55], v22, s[28:31], s13 offen nt
s_add_u32 s13, s13, 0x8000
buffer_load_dwordx4 v[56:59], v22, s[28:31], s13 offen nt
s_add_u32 s13, s13, 0x8000
buffer_load_dwordx4 v[60:63], v22, s[28:31], s13 offen nt
s_add_u32 s13, s13, 0x8000
buffer_load_dwordx4 v[64:67], v22, s[28:31], s13 offen nt
s_add_u32 s13, s13, 0x8000
buffer_load_dwordx4 v[68:71], v22, s[28:31], s13 offen nt
s_add_u32 s13, s13, 0x8000
buffer_load_dwordx4 v[72:75], v22, s[28:31], s13 offen nt
s_add_u32 s13, s13, 0x8000
buffer_load_dwordx4 v[76:79], v22, s[28:31], s13 offen nt
s_add_u32 s13, s13, 0x8000
buffer_load_dwordx4 v[80:83], v22, s[28:31], s13 offen nt
s_add_u32 s13, s13, 0x8000
buffer_load_dwordx4 v[84:87], v22, s[28:31], s13 offen nt
s_add_u32 s13, s13, 0x8000
buffer_load_dwordx4 v[88:91], v22, s[28:31], s13 offen nt
s_add_u32 s13, s13, 0x8000
buffer_load_dwordx4 v[92:95], v22, s[28:31], s13 offen nt
s_mov_b32 s38, 0x158000
s_mov_b32 s39, 0x20000
s_mul_i32 s7, s3, 43
s_lshr_b32 s7, s7, 3
s_add_u32 s12, s3, 1
s_mul_i32 s12, s12, 43
s_lshr_b32 s12, s12, 3
s_sub_u32 s8, s12, s7
v_lshlrev_b32 v24, 1, v3
v_lshrrev_b32 v25, 3, v2
v_add_u32 v24, v24, v25
v_lshlrev_b32 v9, 2, v24
s_lshl_b32 s14, s4, 6
v_add_u32 v24, s14, v24
s_movk_i32 s14, 2752
v_mul_lo_u32 v24, v24, s14
v_and_b32 v25, 7, v2
v_add_u32 v26, s7, v25
v_lshlrev_b32 v26, 4, v26
v_add_u32 v24, v24, v26
v_cmp_gt_u32 vcc, s8, v25
v_mov_b32 v27, 0x80000000
s_mov_b32 s13, 0
s_nop 0
v_cndmask_b32 v24, v27, v24, vcc
buffer_load_dwordx4 v[96:99], v24, s[36:39], s13 offen nt
s_add_u32 s13, s13, 22016
buffer_load_dwordx4 v[100:103], v24, s[36:39], s13 offen nt
s_add_u32 s13, s13, 22016
buffer_load_dwordx4 v[104:107], v24, s[36:39], s13 offen nt
s_add_u32 s13, s13, 22016
buffer_load_dwordx4 v[108:111], v24, s[36:39], s13 offen nt
s_add_u32 s13, s13, 22016
buffer_load_dwordx4 v[112:115], v24, s[36:39], s13 offen nt
s_add_u32 s13, s13, 22016
buffer_load_dwordx4 v[116:119], v24, s[36:39], s13 offen nt
s_add_u32 s13, s13, 22016
buffer_load_dwordx4 v[120:123], v24, s[36:39], s13 offen nt
s_add_u32 s13, s13, 22016
buffer_load_dwordx4 v[124:127], v24, s[36:39], s13 offen nt
s_barrier
s_mov_b32 s50, 0x10000000
s_mov_b32 s51, 0x20000
s_mov_b32 s46, 0x400
s_mov_b32 s47, 0x20000
s_mov_b32 s56, 0xff00ff00
s_mov_b32 s57, 0xff00ff00
s_mov_b32 s58, 0xaaaaaaaa
s_mov_b32 s59, 0xaaaaaaaa
s_mov_b32 s62, 0x3fb8aa3b
v_mov_b32 v22, 0xffff
v_mov_b32 v23, 0xffff0000
v_cndmask_b32 v22, v22, v23, s[58:59]
v_bfe_u32 v23, v2, 1, 2
v_cmp_eq_u32 vcc, 0, v23
s_nop 1
v_cndmask_b32 v4, 0, v22, vcc
v_cmp_eq_u32 vcc, 1, v23
s_nop 1
v_cndmask_b32 v5, 0, v22, vcc
v_cmp_eq_u32 vcc, 2, v23
s_nop 1
v_cndmask_b32 v6, 0, v22, vcc
v_cmp_eq_u32 vcc, 3, v23
s_nop 1
v_cndmask_b32 v7, 0, v22, vcc
s_mov_b32 s60, 0
s_mov_b32 s61, -1
s_getreg_b32 s66, hwreg(HW_REG_XCC_ID, 0, 4)
v_lshlrev_b32 v10, 2, v1
v_lshlrev_b32 v11, 2, v3
s_waitcnt vmcnt(25)
v_lshlrev_b32 v20, 16, v16
v_and_b32 v21, 0xffff0000, v16
v_lshlrev_b32 v22, 16, v17
v_and_b32 v23, 0xffff0000, v17
v_lshlrev_b32 v24, 16, v18
v_and_b32 v25, 0xffff0000, v18
v_lshlrev_b32 v26, 16, v19
v_and_b32 v27, 0xffff0000, v19
v_add_f32 v28, v20, v21
v_add_f32 v29, v22, v23
v_add_f32 v30, v24, v25
v_add_f32 v31, v26, v27
v_add_f32 v28, v28, v29
v_add_f32 v30, v30, v31
v_add_f32 v28, v28, v30
s_nop 1
v_add_f32_dpp v28, v28, v28 quad_perm:[1,0,3,2] row_mask:0xf bank_mask:0xf
s_nop 1
v_add_f32_dpp v28, v28, v28 quad_perm:[2,3,0,1] row_mask:0xf bank_mask:0xf
s_nop 1
v_add_f32_dpp v28, v28, v28 row_half_mirror row_mask:0xf bank_mask:0xf
s_nop 1
v_add_f32_dpp v28, v28, v28 row_mirror row_mask:0xf bank_mask:0xf
s_nop 1
v_add_f32_dpp v28, v28, v28 row_bcast:15 row_mask:0xa bank_mask:0xf
s_nop 1
v_add_f32_dpp v28, v28, v28 row_bcast:31 row_mask:0xc bank_mask:0xf
s_nop 1
v_readlane_b32 s12, v28, 63
s_nop 1
v_mov_b32 v29, s12
v_mul_f32 v29, 0x3b000000, v29
v_sub_f32 v20, v20, v29
v_sub_f32 v21, v21, v29
v_sub_f32 v22, v22, v29
v_sub_f32 v23, v23, v29
v_sub_f32 v24, v24, v29
v_sub_f32 v25, v25, v29
v_sub_f32 v26, v26, v29
v_sub_f32 v27, v27, v29
v_mul_f32 v28, v20, v20
v_fmac_f32 v28, v21, v21
v_fmac_f32 v28, v22, v22
v_fmac_f32 v28, v23, v23
v_fmac_f32 v28, v24, v24
v_fmac_f32 v28, v25, v25
v_fmac_f32 v28, v26, v26
v_fmac_f32 v28, v27, v27
s_nop 1
v_add_f32_dpp v28, v28, v28 quad_perm:[1,0,3,2] row_mask:0xf bank_mask:0xf
s_nop 1
v_add_f32_dpp v28, v28, v28 quad_perm:[2,3,0,1] row_mask:0xf bank_mask:0xf
s_nop 1
v_add_f32_dpp v28, v28, v28 row_half_mirror row_mask:0xf bank_mask:0xf
s_nop 1
v_add_f32_dpp v28, v28, v28 row_mirror row_mask:0xf bank_mask:0xf
s_nop 1
v_add_f32_dpp v28, v28, v28 row_bcast:15 row_mask:0xa bank_mask:0xf
s_nop 1
v_add_f32_dpp v28, v28, v28 row_bcast:31 row_mask:0xc bank_mask:0xf
s_nop 1
v_readlane_b32 s13, v28, 63
s_nop 1
v_mov_b32 v30, s13
v_mul_f32 v30, 0x3b000000, v30
v_cvt_pk_bf16_f32 v29, v29, v30
v_and_b32 v30, 0xffff0000, v29
v_lshlrev_b32 v29, 16, v29
v_add_f32 v30, 0x3727c5ac, v30
v_cvt_pk_bf16_f32 v30, v30, v30
v_and_b32 v30, 0xffff0000, v30
v_sqrt_f32 v30, v30
s_nop 0
v_cvt_pk_bf16_f32 v30, v30, v30
v_and_b32 v30, 0xffff0000, v30
v_rcp_f32 v30, v30
s_waitcnt vmcnt(24)
v_lshlrev_b32 v20, 16, v8
v_sub_f32 v20, v20, v29
v_cvt_pk_bf16_f32 v20, v20, v20
v_and_b32 v20, 0xffff0000, v20
v_mul_f32 v20, v20, v30
v_cvt_pk_bf16_f32 v20, v20, v20
ds_write_b32 v10, v20 offset:768
s_waitcnt lgkmcnt(0)
ds_read2_b32 v[224:225], v11 offset0:192 offset1:196
ds_read2_b32 v[226:227], v11 offset0:200 offset1:204
ds_read2_b32 v[228:229], v11 offset0:208 offset1:212
ds_read2_b32 v[230:231], v11 offset0:216 offset1:220
ds_read2_b32 v[232:233], v11 offset0:224 offset1:228
ds_read2_b32 v[234:235], v11 offset0:232 offset1:236
ds_read2_b32 v[236:237], v11 offset0:240 offset1:244
ds_read2_b32 v[238:239], v11 offset0:248 offset1:252
v_add_u32 v9, 768, v9
ds_read2_b32 v[10:11], v9 offset0:0 offset1:8
ds_read2_b32 v[12:13], v9 offset0:16 offset1:24
ds_read2_b32 v[14:15], v9 offset0:32 offset1:40
ds_read2_b32 v[16:17], v9 offset0:48 offset1:56
s_waitcnt lgkmcnt(11)
v_and_b32 v128, v224, v4
v_and_b32 v129, v224, v5
v_and_b32 v130, v224, v6
v_and_b32 v131, v224, v7
v_and_b32 v132, v225, v4
v_and_b32 v133, v225, v5
v_and_b32 v134, v225, v6
v_and_b32 v135, v225, v7
s_waitcnt lgkmcnt(10)
v_and_b32 v136, v226, v4
v_and_b32 v137, v226, v5
v_and_b32 v138, v226, v6
v_and_b32 v139, v226, v7
v_and_b32 v140, v227, v4
v_and_b32 v141, v227, v5
v_and_b32 v142, v227, v6
v_and_b32 v143, v227, v7
s_waitcnt lgkmcnt(9)
v_and_b32 v144, v228, v4
v_and_b32 v145, v228, v5
v_and_b32 v146, v228, v6
v_and_b32 v147, v228, v7
v_and_b32 v148, v229, v4
v_and_b32 v149, v229, v5
v_and_b32 v150, v229, v6
v_and_b32 v151, v229, v7
s_waitcnt lgkmcnt(8)
v_and_b32 v152, v230, v4
v_and_b32 v153, v230, v5
v_and_b32 v154, v230, v6
v_and_b32 v155, v230, v7
v_and_b32 v156, v231, v4
v_and_b32 v157, v231, v5
v_and_b32 v158, v231, v6
v_and_b32 v159, v231, v7
s_waitcnt lgkmcnt(7)
v_and_b32 v160, v232, v4
v_and_b32 v161, v232, v5
v_and_b32 v162, v232, v6
v_and_b32 v163, v232, v7
v_and_b32 v164, v233, v4
v_and_b32 v165, v233, v5
v_and_b32 v166, v233, v6
v_and_b32 v167, v233, v7
s_waitcnt lgkmcnt(6)
v_and_b32 v168, v234, v4
v_and_b32 v169, v234, v5
v_and_b32 v170, v234, v6
v_and_b32 v171, v234, v7
v_and_b32 v172, v235, v4
v_and_b32 v173, v235, v5
v_and_b32 v174, v235, v6
v_and_b32 v175, v235, v7
s_waitcnt lgkmcnt(5)
v_and_b32 v176, v236, v4
v_and_b32 v177, v236, v5
v_and_b32 v178, v236, v6
v_and_b32 v179, v236, v7
v_and_b32 v180, v237, v4
v_and_b32 v181, v237, v5
v_and_b32 v182, v237, v6
v_and_b32 v183, v237, v7
s_waitcnt lgkmcnt(4)
v_and_b32 v184, v238, v4
v_and_b32 v185, v238, v5
v_and_b32 v186, v238, v6
v_and_b32 v187, v238, v7
v_and_b32 v188, v239, v4
v_and_b32 v189, v239, v5
v_and_b32 v190, v239, v6
v_and_b32 v191, v239, v7
s_waitcnt lgkmcnt(3)
v_and_b32 v192, v10, v4
v_and_b32 v193, v10, v5
v_and_b32 v194, v10, v6
v_and_b32 v195, v10, v7
v_and_b32 v196, v11, v4
v_and_b32 v197, v11, v5
v_and_b32 v198, v11, v6
v_and_b32 v199, v11, v7
s_waitcnt lgkmcnt(2)
v_and_b32 v200, v12, v4
v_and_b32 v201, v12, v5
v_and_b32 v202, v12, v6
v_and_b32 v203, v12, v7
v_and_b32 v204, v13, v4
v_and_b32 v205, v13, v5
v_and_b32 v206, v13, v6
v_and_b32 v207, v13, v7
s_waitcnt lgkmcnt(1)
v_and_b32 v208, v14, v4
v_and_b32 v209, v14, v5
v_and_b32 v210, v14, v6
v_and_b32 v211, v14, v7
v_and_b32 v212, v15, v4
v_and_b32 v213, v15, v5
v_and_b32 v214, v15, v6
v_and_b32 v215, v15, v7
s_waitcnt lgkmcnt(0)
v_and_b32 v216, v16, v4
v_and_b32 v217, v16, v5
v_and_b32 v218, v16, v6
v_and_b32 v219, v16, v7
v_and_b32 v220, v17, v4
v_and_b32 v221, v17, v5
v_and_b32 v222, v17, v6
v_and_b32 v223, v17, v7
s_waitcnt vmcnt(20)
v_mfma_f32_16x16x32_bf16 v[240:243], v[128:131], v[32:35], 0
v_mfma_f32_16x16x32_bf16 v[240:243], v[132:135], v[36:39], v[240:243]
v_mfma_f32_16x16x32_bf16 v[240:243], v[136:139], v[40:43], v[240:243]
v_mfma_f32_16x16x32_bf16 v[240:243], v[140:143], v[44:47], v[240:243]
s_waitcnt vmcnt(16)
v_mfma_f32_16x16x32_bf16 v[240:243], v[144:147], v[48:51], v[240:243]
v_mfma_f32_16x16x32_bf16 v[240:243], v[148:151], v[52:55], v[240:243]
v_mfma_f32_16x16x32_bf16 v[240:243], v[152:155], v[56:59], v[240:243]
v_mfma_f32_16x16x32_bf16 v[240:243], v[156:159], v[60:63], v[240:243]
s_waitcnt vmcnt(12)
v_mfma_f32_16x16x32_bf16 v[240:243], v[160:163], v[64:67], v[240:243]
v_mfma_f32_16x16x32_bf16 v[240:243], v[164:167], v[68:71], v[240:243]
v_mfma_f32_16x16x32_bf16 v[240:243], v[168:171], v[72:75], v[240:243]
v_mfma_f32_16x16x32_bf16 v[240:243], v[172:175], v[76:79], v[240:243]
s_waitcnt vmcnt(8)
v_mfma_f32_16x16x32_bf16 v[240:243], v[176:179], v[80:83], v[240:243]
v_mfma_f32_16x16x32_bf16 v[240:243], v[180:183], v[84:87], v[240:243]
v_mfma_f32_16x16x32_bf16 v[240:243], v[184:187], v[88:91], v[240:243]
v_mfma_f32_16x16x32_bf16 v[240:243], v[188:191], v[92:95], v[240:243]
s_waitcnt vmcnt(4)
v_mfma_f32_16x16x32_bf16 v[244:247], v[192:195], v[96:99], 0
v_mfma_f32_16x16x32_bf16 v[244:247], v[196:199], v[100:103], v[244:247]
v_mfma_f32_16x16x32_bf16 v[244:247], v[200:203], v[104:107], v[244:247]
v_mfma_f32_16x16x32_bf16 v[244:247], v[204:207], v[108:111], v[244:247]
s_waitcnt vmcnt(0)
v_mfma_f32_16x16x32_bf16 v[244:247], v[208:211], v[112:115], v[244:247]
v_mfma_f32_16x16x32_bf16 v[244:247], v[212:215], v[116:119], v[244:247]
v_mfma_f32_16x16x32_bf16 v[244:247], v[216:219], v[120:123], v[244:247]
v_mfma_f32_16x16x32_bf16 v[244:247], v[220:223], v[124:127], v[244:247]
v_and_b32 v20, 1, v3
v_lshlrev_b32 v23, 4, v20
v_lshlrev_b32 v20, 1, v20
v_lshlrev_b32 v21, 2, v2
v_add_u32 v21, v21, v20
v_lshrrev_b32 v22, 1, v3
v_add_u32 v21, v21, v22
v_and_b32 v24, 7, v2
v_lshlrev_b32 v24, 5, v24
v_add_u32 v24, v24, v23
v_lshrrev_b32 v25, 3, v2
v_lshlrev_b32 v25, 8, v25
v_add_u32 v24, v24, v25
v_lshlrev_b32 v104, 4, v21
v_lshlrev_b32 v21, 2, v21
s_mov_b32 exec_lo, 0x00ff00ff
s_mov_b32 exec_hi, 0xff00ff00
ds_write_b128 v24, v[244:247] offset:1024
s_mov_b64 exec, -1
s_lshl_b32 s67, s3, 3
s_add_u32 s67, s67, s4
s_lshl_b32 s67, s67, 10
s_add_u32 s67, s67, 8192
s_waitcnt lgkmcnt(0)
ds_read_b32 v102, v21 offset:1024
ds_read_b32 v28, v21 offset:1280
s_mul_i32 s6, s6, 0x9e3779b1
s_add_u32 s6, s6, 0x7f4a7c15
v_cndmask_b32 v100, v240, v242, s[60:61]
v_cndmask_b32 v101, v241, v243, s[60:61]
v_mov_b32 v103, s6
s_waitcnt lgkmcnt(0)
v_add_f32 v102, v102, v28
s_nop 0
v_writelane_b32 v102, s66, 63
buffer_store_dwordx4 v[100:103], v104, s[48:51], s67 offen
v_lshlrev_b32 v20, 4, v1
v_add_u32 v21, 1024, v20
v_add_u32 v22, 2048, v20
v_add_u32 v23, 3072, v20
s_lshl_b32 s12, s3, 13
s_add_u32 s12, s12, 8192
s_add_u32 s13, s12, 4096
s_mov_b32 s53, 0
s_mov_b32 s9, 0
s_waitcnt vmcnt(0)
L_x0_poll:
buffer_load_dwordx4 v[48:51], v20, s[48:51], s12 offen sc1
buffer_load_dwordx4 v[52:55], v21, s[48:51], s12 offen sc1
buffer_load_dwordx4 v[56:59], v22, s[48:51], s12 offen sc1
buffer_load_dwordx4 v[60:63], v23, s[48:51], s12 offen sc1
buffer_load_dwordx4 v[64:67], v20, s[48:51], s13 offen sc1
buffer_load_dwordx4 v[68:71], v21, s[48:51], s13 offen sc1
buffer_load_dwordx4 v[72:75], v22, s[48:51], s13 offen sc1
buffer_load_dwordx4 v[76:79], v23, s[48:51], s13 offen sc1
s_waitcnt vmcnt(0)
v_min3_u32 v24, v51, v55, v59
v_max3_u32 v25, v51, v55, v59
v_min3_u32 v24, v24, v63, v67
v_max3_u32 v25, v25, v63, v67
v_min3_u32 v24, v24, v71, v75
v_max3_u32 v25, v25, v71, v75
v_min_u32 v24, v24, v79
v_max_u32 v25, v25, v79
v_xor_b32 v24, s6, v24
v_xor_b32 v25, s6, v25
v_or_b32 v24, v24, v25
v_cmp_ne_u32 vcc, 0, v24
s_cbranch_vccnz L_x0_retry
s_branch L_x0_ok
L_x0_retry:
s_add_u32 s53, s53, 1
s_cmp_lg_u32 s53, 4
s_cbranch_scc1 L_x0_norep
s_cmp_lg_u32 s9, 0
s_cbranch_scc1 L_x0_norep
buffer_store_dwordx4 v[100:103], v104, s[48:51], s67 offen sc1
s_mov_b32 s9, 1
L_x0_norep:
s_cmp_le_u32 s53, 100000
s_cbranch_scc1 L_x0_poll
L_x0_ok:
v_min3_u32 v24, v50, v54, v58
v_max3_u32 v25, v50, v54, v58
v_min3_u32 v24, v24, v62, v66
v_max3_u32 v25, v25, v62, v66
v_min3_u32 v24, v24, v70, v74
v_max3_u32 v25, v25, v70, v74
v_min_u32 v24, v24, v78
v_max_u32 v25, v25, v78
v_xor_b32 v24, v24, v25
v_add_f32 v48, v48, v52
v_add_f32 v56, v56, v60
v_add_f32 v64, v64, v68
v_add_f32 v72, v72, v76
v_add_f32 v49, v49, v53
v_add_f32 v57, v57, v61
v_add_f32 v65, v65, v69
v_add_f32 v73, v73, v77
v_add_f32 v50, v50, v54
v_add_f32 v58, v58, v62
v_add_f32 v66, v66, v70
v_add_f32 v74, v74, v78
v_readlane_b32 s14, v24, 63
v_add_f32 v48, v48, v56
v_add_f32 v64, v64, v72
v_add_f32 v49, v49, v57
v_add_f32 v65, v65, v73
v_add_f32 v50, v50, v58
v_add_f32 v66, v66, v74
v_add_f32 v48, v48, v64
v_add_f32 v49, v49, v65
v_add_f32 v50, v50, v66
v_cvt_pk_bf16_f32 v24, v48, v49
v_cvt_pk_bf16_f32 v25, v50, v50
v_lshlrev_b32 v22, 2, v1
ds_write_b32 v22, v24 offset:0
s_cmp_eq_u32 s14, 0
s_cselect_b32 s65, 1, 0
s_cbranch_scc1 L_x0_nr2
s_cmp_lg_u32 s9, 0
s_cbranch_scc1 L_x0_nr2
buffer_store_dwordx4 v[100:103], v104, s[48:51], s67 offen sc1
L_x0_nr2:
v_and_b32 v25, 0xffff0000, v25
v_mul_f32 v27, s62, v25
v_exp_f32 v27, -v27
s_nop 0
v_add_f32 v27, 1.0, v27
v_rcp_f32 v27, v27
s_nop 0
v_mul_f32 v25, v25, v27
v_cvt_pk_bf16_f32 v25, v25, v25
ds_write_b32 v22, v25 offset:256
s_waitcnt lgkmcnt(0)
s_barrier
v_lshlrev_b32 v22, 3, v1
v_lshlrev_b32 v23, 4, v1
v_mov_b32 v24, 0
s_lshl_b32 s12, s3, 3
s_add_u32 s12, s12, s4
s_lshl_b32 s12, s12, 11
s_add_u32 s12, s12, 270336
v_mov_b32 v41, s6
v_mov_b32 v43, s6
v_mov_b32 v53, s6
v_mov_b32 v55, s6
v_add_u32 v25, 1024, v23
v_add_u32 v26, 2048, v23
s_lshl_b32 s13, s3, 14
s_add_u32 s13, s13, 270336
s_add_u32 s14, s13, 4096
s_add_u32 s15, s13, 8192
s_add_u32 s52, s13, 12288
v_and_b32 v27, 7, v1
v_lshlrev_b32 v27, 11, v27
v_add_u32 v27, 1024, v27
v_add_u32 v27, s13, v27
s_barrier
ds_read_b128 v[48:51], v24 offset:512
ds_read_b128 v[44:47], v24 offset:528
ds_read_b64 v[32:33], v22 offset:1024
ds_read_b64 v[34:35], v22 offset:1536
ds_read_b64 v[36:37], v22 offset:2048
ds_read_b64 v[38:39], v22 offset:2560
s_waitcnt lgkmcnt(5)
v_max_f32 v52, v48, v49
v_max3_f32 v52, v52, v50, v51
v_sub_f32 v48, v48, v52
v_sub_f32 v49, v49, v52
v_sub_f32 v50, v50, v52
v_sub_f32 v51, v51, v52
v_mul_f32 v48, s62, v48
v_mul_f32 v49, s62, v49
v_mul_f32 v50, s62, v50
v_mul_f32 v51, s62, v51
v_exp_f32 v48, v48
v_exp_f32 v49, v49
v_exp_f32 v50, v50
v_exp_f32 v51, v51
s_waitcnt lgkmcnt(0)
v_mul_f32 v40, v48, v32
v_mul_f32 v42, v48, v33
v_mul_f32 v54, v48, v44
v_fmac_f32 v40, v49, v34
v_fmac_f32 v42, v49, v35
v_fmac_f32 v54, v49, v45
v_fmac_f32 v40, v50, v36
v_fmac_f32 v42, v50, v37
v_fmac_f32 v54, v50, v46
v_fmac_f32 v40, v51, v38
v_fmac_f32 v42, v51, v39
v_fmac_f32 v54, v51, v47
s_cmp_eq_u32 s65, 0
s_cbranch_scc1 L_pub1_slow
buffer_store_dwordx4 v[40:43], v23, s[48:51], s12 offen
s_mov_b64 exec, 0xff
buffer_store_dwordx4 v[52:55], v25, s[48:51], s12 offen
s_branch L_pub1_done
L_pub1_slow:
buffer_store_dwordx4 v[40:43], v23, s[48:51], s12 offen sc1
s_mov_b64 exec, 0xff
buffer_store_dwordx4 v[52:55], v25, s[48:51], s12 offen sc1
L_pub1_done:
s_mov_b64 exec, -1
s_mov_b32 s53, 0
L_x1_poll:
buffer_load_dwordx4 v[64:67], v23, s[48:51], s13 offen sc1
buffer_load_dwordx4 v[68:71], v26, s[48:51], s13 offen sc1
buffer_load_dwordx4 v[72:75], v23, s[48:51], s14 offen sc1
buffer_load_dwordx4 v[76:79], v26, s[48:51], s14 offen sc1
buffer_load_dwordx4 v[80:83], v23, s[48:51], s15 offen sc1
buffer_load_dwordx4 v[84:87], v26, s[48:51], s15 offen sc1
buffer_load_dwordx4 v[88:91], v23, s[48:51], s52 offen sc1
buffer_load_dwordx4 v[92:95], v26, s[48:51], s52 offen sc1
buffer_load_dwordx4 v[96:99], v27, s[48:51], 0 offen sc1
s_waitcnt vmcnt(0)
v_min3_u32 v28, v65, v67, v69
v_max3_u32 v29, v65, v67, v69
v_min3_u32 v28, v28, v71, v73
v_max3_u32 v29, v29, v71, v73
v_min3_u32 v28, v28, v75, v77
v_max3_u32 v29, v29, v75, v77
v_min3_u32 v28, v28, v79, v81
v_max3_u32 v29, v29, v79, v81
v_min3_u32 v28, v28, v83, v85
v_max3_u32 v29, v29, v83, v85
v_min3_u32 v28, v28, v87, v89
v_max3_u32 v29, v29, v87, v89
v_min3_u32 v28, v28, v91, v93
v_max3_u32 v29, v29, v91, v93
v_min3_u32 v28, v28, v95, v97
v_max3_u32 v29, v29, v95, v97
v_min_u32 v28, v28, v99
v_max_u32 v29, v29, v99
v_xor_b32 v28, s6, v28
v_xor_b32 v29, s6, v29
v_or_b32 v28, v28, v29
v_cmp_ne_u32 vcc, 0, v28
s_cbranch_vccnz L_x1_retry
s_branch L_x1_ok
L_x1_retry:
s_add_u32 s53, s53, 1
s_cmp_le_u32 s53, 100000
s_cbranch_scc1 L_x1_poll
L_x1_ok:
v_max_f32_dpp v28, v96, v96 quad_perm:[1,0,3,2] row_mask:0xf bank_mask:0xf
s_nop 1
v_max_f32_dpp v28, v28, v28 quad_perm:[2,3,0,1] row_mask:0xf bank_mask:0xf
s_nop 1
v_max_f32_dpp v28, v28, v28 row_half_mirror row_mask:0xf bank_mask:0xf
v_sub_f32 v28, v96, v28
v_mul_f32 v28, s62, v28
v_exp_f32 v28, v28
s_nop 0
v_mul_f32 v29, v28, v98
s_nop 0
v_mul_f32_dpp v30, v28, v64 row_newbcast:0 row_mask:0xf bank_mask:0xf
v_mul_f32_dpp v31, v28, v66 row_newbcast:0 row_mask:0xf bank_mask:0xf
v_fmac_f32_dpp v30, v28, v68 row_newbcast:1 row_mask:0xf bank_mask:0xf
v_fmac_f32_dpp v31, v28, v70 row_newbcast:1 row_mask:0xf bank_mask:0xf
v_add_f32_dpp v29, v29, v29 quad_perm:[1,0,3,2] row_mask:0xf bank_mask:0xf
v_fmac_f32_dpp v30, v28, v72 row_newbcast:2 row_mask:0xf bank_mask:0xf
v_fmac_f32_dpp v31, v28, v74 row_newbcast:2 row_mask:0xf bank_mask:0xf
v_fmac_f32_dpp v30, v28, v76 row_newbcast:3 row_mask:0xf bank_mask:0xf
v_fmac_f32_dpp v31, v28, v78 row_newbcast:3 row_mask:0xf bank_mask:0xf
v_add_f32_dpp v29, v29, v29 quad_perm:[2,3,0,1] row_mask:0xf bank_mask:0xf
v_fmac_f32_dpp v30, v28, v80 row_newbcast:4 row_mask:0xf bank_mask:0xf
v_fmac_f32_dpp v31, v28, v82 row_newbcast:4 row_mask:0xf bank_mask:0xf
v_fmac_f32_dpp v30, v28, v84 row_newbcast:5 row_mask:0xf bank_mask:0xf
v_fmac_f32_dpp v31, v28, v86 row_newbcast:5 row_mask:0xf bank_mask:0xf
v_add_f32_dpp v29, v29, v29 row_half_mirror row_mask:0xf bank_mask:0xf
v_fmac_f32_dpp v30, v28, v88 row_newbcast:6 row_mask:0xf bank_mask:0xf
v_fmac_f32_dpp v31, v28, v90 row_newbcast:6 row_mask:0xf bank_mask:0xf
v_rcp_f32 v29, v29
v_fmac_f32_dpp v30, v28, v92 row_newbcast:7 row_mask:0xf bank_mask:0xf
v_fmac_f32_dpp v31, v28, v94 row_newbcast:7 row_mask:0xf bank_mask:0xf
v_mul_f32 v30, v30, v29
v_mul_f32 v31, v31, v29
v_cvt_pk_bf16_f32 v30, v30, v30
v_cvt_pk_bf16_f32 v31, v31, v31
ds_write_b64 v22, v[30:31] offset:3072
s_lshl_b32 s12, s4, 15
s_lshl_b32 s52, s3, 7
s_add_u32 s12, s12, s52
s_add_u32 s12, s12, 794624
s_waitcnt lgkmcnt(0)
s_barrier
v_lshrrev_b32 v24, 1, v1
v_and_b32 v25, 1, v1
v_lshlrev_b32 v22, 3, v24
v_mul_u32_u24 v26, 2048, v25
v_add_u32 v22, v22, v26
v_lshrrev_b32 v23, 3, v1
v_lshlrev_b32 v23, 12, v23
v_and_b32 v24, 7, v1
v_lshlrev_b32 v24, 4, v24
v_add_u32 v23, v23, v24
v_lshlrev_b32 v26, 4, v1
s_lshl_b32 s13, s4, 15
s_lshr_b32 s14, s3, 2
s_lshl_b32 s14, s14, 12
s_add_u32 s13, s13, s14
s_add_u32 s13, s13, 794624
v_bfe_u32 v25, v1, 1, 2
v_lshlrev_b32 v25, 2, v25
s_lshl_b32 s14, s4, 7
s_lshr_b32 s15, s3, 2
s_lshl_b32 s15, s15, 4
s_add_u32 s14, s14, s15
v_add_u32 v25, s14, v25
v_mov_b32 v41, s6
v_mov_b32 v43, s6
s_barrier
ds_read_b64 v[44:45], v22 offset:3584
ds_read_b64 v[46:47], v22 offset:3840
ds_read_b64 v[48:49], v22 offset:4096
ds_read_b64 v[50:51], v22 offset:4352
ds_read_b64 v[52:53], v22 offset:4608
ds_read_b64 v[54:55], v22 offset:4864
ds_read_b64 v[56:57], v22 offset:5120
ds_read_b64 v[58:59], v22 offset:5376
s_waitcnt lgkmcnt(0)
v_add_f32 v44, v44, v46
v_add_f32 v45, v45, v47
v_add_f32 v48, v48, v50
v_add_f32 v49, v49, v51
v_add_f32 v52, v52, v54
v_add_f32 v53, v53, v55
v_add_f32 v56, v56, v58
v_add_f32 v57, v57, v59
v_add_f32 v44, v44, v48
v_add_f32 v45, v45, v49
v_add_f32 v52, v52, v56
v_add_f32 v53, v53, v57
v_add_f32 v40, v44, v52
v_add_f32 v42, v45, v53
buffer_store_dwordx4 v[40:43], v23, s[48:51], s12 offen sc1
s_and_b32 s14, s3, 3
s_cmp_lg_u32 s14, 0
s_cbranch_scc1 L_fin
buffer_load_dword v60, v25, s[16:19], 0 offen
s_mov_b32 s53, 0
L_x2_poll:
buffer_load_dwordx4 v[64:67], v26, s[48:51], s13 offen offset:0 sc1
buffer_load_dwordx4 v[68:71], v26, s[48:51], s13 offen offset:1024 sc1
buffer_load_dwordx4 v[72:75], v26, s[48:51], s13 offen offset:2048 sc1
buffer_load_dwordx4 v[76:79], v26, s[48:51], s13 offen offset:3072 sc1
s_waitcnt vmcnt(0)
v_min3_u32 v28, v65, v67, v69
v_max3_u32 v29, v65, v67, v69
v_min3_u32 v28, v28, v71, v73
v_max3_u32 v29, v29, v71, v73
v_min3_u32 v28, v28, v75, v77
v_max3_u32 v29, v29, v75, v77
v_min_u32 v28, v28, v79
v_max_u32 v29, v29, v79
v_xor_b32 v28, s6, v28
v_xor_b32 v29, s6, v29
v_or_b32 v28, v28, v29
v_cmp_ne_u32 vcc, 0, v28
s_cbranch_vccnz L_x2_retry
s_branch L_x2_ok
L_x2_retry:
s_add_u32 s53, s53, 1
s_cmp_le_u32 s53, 100000
s_cbranch_scc1 L_x2_poll
L_x2_ok:
v_add_f32 v32, v64, v68
v_add_f32 v34, v66, v70
v_add_f32 v36, v72, v76
v_add_f32 v37, v74, v78
v_add_f32 v32, v32, v36
v_add_f32 v34, v34, v37
s_nop 0
s_nop 0
v_add_f32_dpp v32, v32, v32 row_ror:8 row_mask:0xf bank_mask:0xf
v_add_f32_dpp v34, v34, v34 row_ror:8 row_mask:0xf bank_mask:0xf
v_mov_b32 v36, v32
v_mov_b32 v37, v34
s_nop 1
v_permlane16_swap_b32 v32, v36
v_permlane16_swap_b32 v34, v37
s_nop 1
v_add_f32 v32, v32, v36
v_add_f32 v34, v34, v37
v_mov_b32 v36, v32
v_mov_b32 v37, v34
s_nop 1
v_permlane32_swap_b32 v32, v36
v_permlane32_swap_b32 v34, v37
s_nop 1
v_add_f32 v32, v32, v36
v_add_f32 v34, v34, v37
v_cvt_pk_bf16_f32 v32, v32, v34
v_lshlrev_b32 v36, 16, v60
v_and_b32 v37, 0xffff0000, v60
v_mov_b32_dpp v33, v32 quad_perm:[1,1,3,3] row_mask:0xf bank_mask:0xf
v_lshlrev_b32 v34, 16, v32
v_and_b32 v35, 0xffff0000, v32
v_add_f32 v34, v36, v34
v_add_f32 v35, v37, v35
v_cvt_pk_bf16_f32 v34, v34, v35
v_lshlrev_b32 v36, 16, v33
v_and_b32 v37, 0xffff0000, v33
v_lshlrev_b32 v35, 16, v34
v_and_b32 v34, 0xffff0000, v34
v_add_f32 v35, v35, v36
v_add_f32 v34, v34, v37
v_cvt_pk_bf16_f32 v32, v35, v34
s_mov_b64 exec, 0x55
buffer_store_dword v32, v25, s[44:47], 0 offen
s_cmp_lg_u32 s2, 0
s_cbranch_scc1 L_fin
v_mov_b32 v33, s6
v_mov_b32 v34, 0
buffer_store_dword v33, v34, s[48:51], 0 offen
s_branch L_fin
L_streamer:
s_waitcnt lgkmcnt(0)
s_mov_b32 s26, 0x4000000
s_mov_b32 s27, 0x20000
s_mov_b32 s34, 0x400000
s_mov_b32 s35, 0x20000
s_mov_b32 s42, 0x158000
s_mov_b32 s43, 0x20000
s_mul_i32 s7, s3, 43
s_lshr_b32 s7, s7, 3
s_add_u32 s12, s3, 1
s_mul_i32 s12, s12, 43
s_lshr_b32 s12, s12, 3
s_sub_u32 s8, s12, s7
s_mov_b32 s63, 0x3db504f3
s_mov_b32 s60, 0xcccccccc
s_mov_b32 s61, 0xcccccccc
s_mov_b32 s56, 0xff00ff00
s_mov_b32 s57, 0xff00ff00
s_mov_b32 s58, 0xaaaaaaaa
s_mov_b32 s59, 0xaaaaaaaa
s_mov_b32 s62, 0x3fb8aa3b
v_mov_b32 v22, 0xffff
v_mov_b32 v23, 0xffff0000
v_cndmask_b32 v22, v22, v23, s[58:59]
v_bfe_u32 v23, v2, 1, 2
v_cmp_eq_u32 vcc, 0, v23
s_nop 1
v_cndmask_b32 v4, 0, v22, vcc
v_cmp_eq_u32 vcc, 1, v23
s_nop 1
v_cndmask_b32 v5, 0, v22, vcc
v_cmp_eq_u32 vcc, 2, v23
s_nop 1
v_cndmask_b32 v6, 0, v22, vcc
v_cmp_eq_u32 vcc, 3, v23
s_nop 1
v_cndmask_b32 v7, 0, v22, vcc
v_lshlrev_b32 v24, 1, v3
v_lshrrev_b32 v26, 3, v2
v_add_u32 v24, v24, v26
v_and_b32 v25, 7, v2
v_lshlrev_b32 v12, 2, v24
v_lshlrev_b32 v24, 10, v24
v_lshlrev_b32 v26, 4, v25
v_add_u32 v24, v24, v26
s_lshl_b32 s13, s4, 7
v_add_u32 v24, s13, v24
s_lshl_b32 s13, s3, 17
s_lshl_b32 s14, s5, 15
s_add_u32 s13, s13, s14
v_add_u32 v9, s13, v24
s_add_u32 s13, s7, s5
s_lshl_b32 s13, s13, 13
v_add_u32 v10, s13, v24
v_add_u32 v11, 0x8000, v10
s_add_u32 s13, s5, 4
s_cmp_lt_u32 s13, s8
s_cbranch_scc1 L_w2ok
v_mov_b32 v11, 0x80000000
L_w2ok:
v_and_b32 v24, 1, v3
v_lshlrev_b32 v24, 4, v24
v_lshlrev_b32 v25, 5, v25
v_add_u32 v25, v25, v24
v_lshrrev_b32 v26, 3, v2
v_lshlrev_b32 v26, 8, v26
v_add_u32 v13, v25, v26
s_lshl_b32 s12, s5, 9
v_add_u32 v13, s12, v13
s_add_u32 s52, s3, s5
s_and_b32 s52, s52, 3
v_mov_b32 v32, 0
v_mov_b32 v33, 0
v_mov_b32 v34, 0
v_mov_b32 v35, 0
v_mov_b32 v36, 0
v_mov_b32 v37, 0
v_mov_b32 v38, 0
v_mov_b32 v39, 0
v_mov_b32 v40, 0
v_mov_b32 v41, 0
v_mov_b32 v42, 0
v_mov_b32 v43, 0
v_mov_b32 v44, 0
v_mov_b32 v45, 0
v_mov_b32 v46, 0
v_mov_b32 v47, 0
s_waitcnt vmcnt(6)
buffer_load_dwordx4 v[92:95], v8, s[20:23], s53 offen nt
s_add_u32 s53, s53, 0x400
s_and_b32 s53, s53, 0x3fff
s_waitcnt vmcnt(6)
buffer_load_dwordx4 v[96:99], v8, s[20:23], s53 offen nt
s_add_u32 s53, s53, 0x400
s_and_b32 s53, s53, 0x3fff
s_waitcnt vmcnt(6)
buffer_load_dwordx4 v[100:103], v8, s[20:23], s53 offen nt
s_add_u32 s53, s53, 0x400
s_and_b32 s53, s53, 0x3fff
s_waitcnt vmcnt(6)
buffer_load_dwordx4 v[104:107], v8, s[20:23], s53 offen nt
s_add_u32 s53, s53, 0x400
s_and_b32 s53, s53, 0x3fff
s_waitcnt vmcnt(6)
buffer_load_dwordx4 v[108:111], v8, s[20:23], s53 offen nt
s_add_u32 s53, s53, 0x400
s_and_b32 s53, s53, 0x3fff
s_waitcnt vmcnt(6)
buffer_load_dwordx4 v[112:115], v8, s[20:23], s53 offen nt
s_add_u32 s53, s53, 0x400
s_and_b32 s53, s53, 0x3fff
s_waitcnt vmcnt(6)
buffer_load_dwordx4 v[116:119], v8, s[20:23], s53 offen nt
s_add_u32 s53, s53, 0x400
s_and_b32 s53, s53, 0x3fff
s_waitcnt vmcnt(6)
buffer_load_dwordx4 v[120:123], v8, s[20:23], s53 offen nt
s_add_u32 s53, s53, 0x400
s_and_b32 s53, s53, 0x3fff
s_waitcnt vmcnt(6)
buffer_load_dwordx4 v[124:127], v8, s[20:23], s53 offen nt
s_add_u32 s53, s53, 0x400
s_and_b32 s53, s53, 0x3fff
s_waitcnt vmcnt(6)
buffer_load_dwordx4 v[128:131], v8, s[24:27], s53 offen nt
s_add_u32 s53, s53, 0x400
s_and_b32 s53, s53, 0x3fff
s_waitcnt vmcnt(6)
buffer_load_dwordx4 v[132:135], v8, s[24:27], s53 offen nt
s_add_u32 s53, s53, 0x400
s_and_b32 s53, s53, 0x3fff
s_waitcnt vmcnt(6)
buffer_load_dwordx4 v[136:139], v8, s[24:27], s53 offen nt
s_add_u32 s53, s53, 0x400
s_and_b32 s53, s53, 0x3fff
s_waitcnt vmcnt(6)
buffer_load_dwordx4 v[140:143], v8, s[24:27], s53 offen nt
s_add_u32 s53, s53, 0x400
s_and_b32 s53, s53, 0x3fff
s_waitcnt vmcnt(6)
buffer_load_dwordx4 v[144:147], v8, s[24:27], s53 offen nt
s_add_u32 s53, s53, 0x400
s_and_b32 s53, s53, 0x3fff
s_waitcnt vmcnt(6)
buffer_load_dwordx4 v[148:151], v8, s[24:27], s53 offen nt
s_add_u32 s53, s53, 0x400
s_and_b32 s53, s53, 0x3fff
s_waitcnt vmcnt(6)
buffer_load_dwordx4 v[152:155], v8, s[24:27], s53 offen nt
s_add_u32 s53, s53, 0x400
s_and_b32 s53, s53, 0x3fff
s_waitcnt vmcnt(6)
buffer_load_dwordx4 v[156:159], v8, s[24:27], s53 offen nt
s_add_u32 s53, s53, 0x400
s_and_b32 s53, s53, 0x3fff
s_waitcnt vmcnt(6)
buffer_load_dwordx4 v[160:163], v8, s[24:27], s53 offen nt
s_add_u32 s53, s53, 0x400
s_and_b32 s53, s53, 0x3fff
s_waitcnt vmcnt(6)
buffer_load_dwordx4 v[164:167], v8, s[24:27], s53 offen nt
s_add_u32 s53, s53, 0x400
s_and_b32 s53, s53, 0x3fff
s_waitcnt vmcnt(6)
buffer_load_dwordx4 v[168:171], v8, s[24:27], s53 offen nt
s_add_u32 s53, s53, 0x400
s_and_b32 s53, s53, 0x3fff
s_waitcnt vmcnt(6)
buffer_load_dwordx4 v[172:175], v8, s[24:27], s53 offen nt
s_add_u32 s53, s53, 0x400
s_and_b32 s53, s53, 0x3fff
s_waitcnt vmcnt(8)
buffer_load_dwordx4 v[176:179], v8, s[24:27], s53 offen nt
s_add_u32 s53, s53, 0x400
s_and_b32 s53, s53, 0x3fff
s_waitcnt vmcnt(8)
buffer_load_dwordx4 v[180:183], v8, s[24:27], s53 offen nt
s_add_u32 s53, s53, 0x400
s_and_b32 s53, s53, 0x3fff
s_waitcnt vmcnt(8)
buffer_load_dwordx4 v[184:187], v8, s[24:27], s53 offen nt
s_add_u32 s53, s53, 0x400
s_and_b32 s53, s53, 0x3fff
s_waitcnt vmcnt(8)
buffer_load_dwordx4 v[188:191], v8, s[24:27], s53 offen nt
s_add_u32 s53, s53, 0x400
s_and_b32 s53, s53, 0x3fff
s_waitcnt vmcnt(8)
s_add_u32 s14, s52, 0
s_and_b32 s14, s14, 3
s_lshl_b32 s14, s14, 13
buffer_load_dwordx4 v[192:195], v9, s[32:35], s14 offen nt
s_waitcnt vmcnt(8)
s_add_u32 s14, s52, 1
s_and_b32 s14, s14, 3
s_lshl_b32 s14, s14, 13
buffer_load_dwordx4 v[196:199], v9, s[32:35], s14 offen nt
s_waitcnt vmcnt(8)
s_add_u32 s14, s52, 2
s_and_b32 s14, s14, 3
s_lshl_b32 s14, s14, 13
buffer_load_dwordx4 v[200:203], v9, s[32:35], s14 offen nt
s_waitcnt vmcnt(8)
s_add_u32 s14, s52, 3
s_and_b32 s14, s14, 3
s_lshl_b32 s14, s14, 13
buffer_load_dwordx4 v[204:207], v9, s[32:35], s14 offen nt
s_waitcnt vmcnt(8)
buffer_load_dwordx4 v[208:211], v10, s[40:43], 0 offen nt
s_waitcnt vmcnt(8)
buffer_load_dwordx4 v[212:215], v11, s[40:43], 0 offen nt
v_lshlrev_b32 v22, 4, v2
s_lshl_b32 s13, s5, 2
v_mov_b32 v23, s13
s_barrier
ds_read_b128 v[24:27], v22 offset:0
s_waitcnt vmcnt(22) lgkmcnt(0)
v_dot2c_f32_bf16 v32, v64, v24
v_dot2c_f32_bf16 v33, v68, v24
v_dot2c_f32_bf16 v34, v72, v24
v_dot2c_f32_bf16 v35, v76, v24
v_dot2c_f32_bf16 v36, v80, v24
v_dot2c_f32_bf16 v37, v84, v24
v_dot2c_f32_bf16 v38, v88, v24
v_dot2c_f32_bf16 v39, v92, v24
v_dot2c_f32_bf16 v40, v96, v24
v_dot2c_f32_bf16 v41, v100, v24
v_dot2c_f32_bf16 v42, v104, v24
v_dot2c_f32_bf16 v43, v108, v24
v_dot2c_f32_bf16 v44, v112, v24
v_dot2c_f32_bf16 v45, v116, v24
v_dot2c_f32_bf16 v46, v120, v24
v_dot2c_f32_bf16 v47, v124, v24
v_dot2c_f32_bf16 v32, v65, v25
v_dot2c_f32_bf16 v33, v69, v25
v_dot2c_f32_bf16 v34, v73, v25
v_dot2c_f32_bf16 v35, v77, v25
v_dot2c_f32_bf16 v36, v81, v25
v_dot2c_f32_bf16 v37, v85, v25
v_dot2c_f32_bf16 v38, v89, v25
v_dot2c_f32_bf16 v39, v93, v25
v_dot2c_f32_bf16 v40, v97, v25
v_dot2c_f32_bf16 v41, v101, v25
v_dot2c_f32_bf16 v42, v105, v25
v_dot2c_f32_bf16 v43, v109, v25
v_dot2c_f32_bf16 v44, v113, v25
v_dot2c_f32_bf16 v45, v117, v25
v_dot2c_f32_bf16 v46, v121, v25
v_dot2c_f32_bf16 v47, v125, v25
v_dot2c_f32_bf16 v32, v66, v26
v_dot2c_f32_bf16 v33, v70, v26
v_dot2c_f32_bf16 v34, v74, v26
v_dot2c_f32_bf16 v35, v78, v26
v_dot2c_f32_bf16 v36, v82, v26
v_dot2c_f32_bf16 v37, v86, v26
v_dot2c_f32_bf16 v38, v90, v26
v_dot2c_f32_bf16 v39, v94, v26
v_dot2c_f32_bf16 v40, v98, v26
v_dot2c_f32_bf16 v41, v102, v26
v_dot2c_f32_bf16 v42, v106, v26
v_dot2c_f32_bf16 v43, v110, v26
v_dot2c_f32_bf16 v44, v114, v26
v_dot2c_f32_bf16 v45, v118, v26
v_dot2c_f32_bf16 v46, v122, v26
v_dot2c_f32_bf16 v47, v126, v26
v_dot2c_f32_bf16 v32, v67, v27
v_dot2c_f32_bf16 v33, v71, v27
v_dot2c_f32_bf16 v34, v75, v27
v_dot2c_f32_bf16 v35, v79, v27
v_dot2c_f32_bf16 v36, v83, v27
v_dot2c_f32_bf16 v37, v87, v27
v_dot2c_f32_bf16 v38, v91, v27
v_dot2c_f32_bf16 v39, v95, v27
v_dot2c_f32_bf16 v40, v99, v27
v_dot2c_f32_bf16 v41, v103, v27
v_dot2c_f32_bf16 v42, v107, v27
v_dot2c_f32_bf16 v43, v111, v27
v_dot2c_f32_bf16 v44, v115, v27
v_dot2c_f32_bf16 v45, v119, v27
v_dot2c_f32_bf16 v46, v123, v27
v_dot2c_f32_bf16 v47, v127, v27
s_nop 2
v_add_f32_dpp v32, v32, v32 row_ror:8 row_mask:0xf bank_mask:0x3
v_add_f32_dpp v32, v40, v40 row_ror:8 row_mask:0xf bank_mask:0xc
v_add_f32_dpp v33, v33, v33 row_ror:8 row_mask:0xf bank_mask:0x3
v_add_f32_dpp v33, v41, v41 row_ror:8 row_mask:0xf bank_mask:0xc
v_add_f32_dpp v34, v34, v34 row_ror:8 row_mask:0xf bank_mask:0x3
v_add_f32_dpp v34, v42, v42 row_ror:8 row_mask:0xf bank_mask:0xc
v_add_f32_dpp v35, v35, v35 row_ror:8 row_mask:0xf bank_mask:0x3
v_add_f32_dpp v35, v43, v43 row_ror:8 row_mask:0xf bank_mask:0xc
v_add_f32_dpp v36, v36, v36 row_ror:8 row_mask:0xf bank_mask:0x3
v_add_f32_dpp v36, v44, v44 row_ror:8 row_mask:0xf bank_mask:0xc
v_add_f32_dpp v37, v37, v37 row_ror:8 row_mask:0xf bank_mask:0x3
v_add_f32_dpp v37, v45, v45 row_ror:8 row_mask:0xf bank_mask:0xc
v_add_f32_dpp v38, v38, v38 row_ror:8 row_mask:0xf bank_mask:0x3
v_add_f32_dpp v38, v46, v46 row_ror:8 row_mask:0xf bank_mask:0xc
v_add_f32_dpp v39, v39, v39 row_ror:8 row_mask:0xf bank_mask:0x3
v_add_f32_dpp v39, v47, v47 row_ror:8 row_mask:0xf bank_mask:0xc
v_add_f32_dpp v32, v32, v32 row_shl:4 row_mask:0xf bank_mask:0x5
v_add_f32_dpp v32, v36, v36 row_shr:4 row_mask:0xf bank_mask:0xa
v_add_f32_dpp v33, v33, v33 row_shl:4 row_mask:0xf bank_mask:0x5
v_add_f32_dpp v33, v37, v37 row_shr:4 row_mask:0xf bank_mask:0xa
v_add_f32_dpp v34, v34, v34 row_shl:4 row_mask:0xf bank_mask:0x5
v_add_f32_dpp v34, v38, v38 row_shr:4 row_mask:0xf bank_mask:0xa
v_add_f32_dpp v35, v35, v35 row_shl:4 row_mask:0xf bank_mask:0x5
v_add_f32_dpp v35, v39, v39 row_shr:4 row_mask:0xf bank_mask:0xa
v_add_f32_dpp v32, v32, v32 quad_perm:[2,3,0,1] row_mask:0xf bank_mask:0xf
v_add_f32_dpp v33, v33, v33 quad_perm:[2,3,0,1] row_mask:0xf bank_mask:0xf
v_add_f32_dpp v34, v34, v34 quad_perm:[2,3,0,1] row_mask:0xf bank_mask:0xf
v_add_f32_dpp v35, v35, v35 quad_perm:[2,3,0,1] row_mask:0xf bank_mask:0xf
v_cndmask_b32 v32, v32, v34, s[60:61]
v_cndmask_b32 v33, v33, v35, s[60:61]
s_nop 0
v_add_f32_dpp v32, v32, v32 quad_perm:[1,0,3,2] row_mask:0xf bank_mask:0xf
v_add_f32_dpp v33, v33, v33 quad_perm:[1,0,3,2] row_mask:0xf bank_mask:0xf
v_cndmask_b32 v32, v32, v33, s[58:59]
v_cvt_pk_bf16_f32 v32, v32, v32
v_and_b32 v32, 0xffff0000, v32
v_mul_f32 v32, s63, v32
v_cvt_pk_bf16_f32 v32, v32, v32
v_and_b32 v32, 0xffff0000, v32
s_nop 1
v_max_f32_dpp v33, v32, v32 quad_perm:[1,0,3,2] row_mask:0xf bank_mask:0xf
s_nop 1
v_max_f32_dpp v33, v33, v33 quad_perm:[2,3,0,1] row_mask:0xf bank_mask:0xf
s_nop 1
v_max_f32_dpp v33, v33, v33 row_half_mirror row_mask:0xf bank_mask:0xf
s_nop 1
v_max_f32_dpp v33, v33, v33 row_mirror row_mask:0xf bank_mask:0xf
s_nop 1
v_max_f32_dpp v33, v33, v33 row_bcast:15 row_mask:0xa bank_mask:0xf
s_nop 1
v_max_f32_dpp v33, v33, v33 row_bcast:31 row_mask:0xc bank_mask:0xf
s_nop 0
v_readlane_b32 s12, v33, 63
s_nop 1
v_subrev_f32 v35, s12, v32
v_mov_b32 v36, s12
v_mul_f32 v35, s62, v35
v_exp_f32 v35, v35
ds_write_b32 v23, v36 offset:512
v_cvt_pk_bf16_f32 v34, v35, v35
s_nop 1
v_and_b32_dpp v64, v34, v4 row_newbcast:0 row_mask:0xf bank_mask:0xf
v_and_b32_dpp v65, v34, v5 row_newbcast:0 row_mask:0xf bank_mask:0xf
v_and_b32_dpp v66, v34, v6 row_newbcast:0 row_mask:0xf bank_mask:0xf
v_and_b32_dpp v67, v34, v7 row_newbcast:0 row_mask:0xf bank_mask:0xf
v_and_b32_dpp v68, v34, v4 row_newbcast:1 row_mask:0xf bank_mask:0xf
v_and_b32_dpp v69, v34, v5 row_newbcast:1 row_mask:0xf bank_mask:0xf
v_and_b32_dpp v70, v34, v6 row_newbcast:1 row_mask:0xf bank_mask:0xf
v_and_b32_dpp v71, v34, v7 row_newbcast:1 row_mask:0xf bank_mask:0xf
v_add_f32_dpp v35, v35, v35 quad_perm:[1,0,3,2] row_mask:0xf bank_mask:0xf
s_waitcnt vmcnt(21)
v_mfma_f32_16x16x32_bf16 v[240:243], v[64:67], v[128:131], 0
v_and_b32_dpp v72, v34, v4 row_newbcast:2 row_mask:0xf bank_mask:0xf
v_and_b32_dpp v73, v34, v5 row_newbcast:2 row_mask:0xf bank_mask:0xf
v_and_b32_dpp v74, v34, v6 row_newbcast:2 row_mask:0xf bank_mask:0xf
v_and_b32_dpp v75, v34, v7 row_newbcast:2 row_mask:0xf bank_mask:0xf
v_add_f32_dpp v35, v35, v35 quad_perm:[2,3,0,1] row_mask:0xf bank_mask:0xf
s_waitcnt vmcnt(20)
v_mfma_f32_16x16x32_bf16 v[240:243], v[68:71], v[132:135], v[240:243]
v_and_b32_dpp v76, v34, v4 row_newbcast:3 row_mask:0xf bank_mask:0xf
v_and_b32_dpp v77, v34, v5 row_newbcast:3 row_mask:0xf bank_mask:0xf
v_and_b32_dpp v78, v34, v6 row_newbcast:3 row_mask:0xf bank_mask:0xf
v_and_b32_dpp v79, v34, v7 row_newbcast:3 row_mask:0xf bank_mask:0xf
v_add_f32_dpp v35, v35, v35 row_half_mirror row_mask:0xf bank_mask:0xf
s_waitcnt vmcnt(19)
v_mfma_f32_16x16x32_bf16 v[240:243], v[72:75], v[136:139], v[240:243]
v_and_b32_dpp v80, v34, v4 row_newbcast:4 row_mask:0xf bank_mask:0xf
v_and_b32_dpp v81, v34, v5 row_newbcast:4 row_mask:0xf bank_mask:0xf
v_and_b32_dpp v82, v34, v6 row_newbcast:4 row_mask:0xf bank_mask:0xf
v_and_b32_dpp v83, v34, v7 row_newbcast:4 row_mask:0xf bank_mask:0xf
v_add_f32_dpp v35, v35, v35 row_mirror row_mask:0xf bank_mask:0xf
s_waitcnt vmcnt(18)
v_mfma_f32_16x16x32_bf16 v[240:243], v[76:79], v[140:143], v[240:243]
v_and_b32_dpp v84, v34, v4 row_newbcast:5 row_mask:0xf bank_mask:0xf
v_and_b32_dpp v85, v34, v5 row_newbcast:5 row_mask:0xf bank_mask:0xf
v_and_b32_dpp v86, v34, v6 row_newbcast:5 row_mask:0xf bank_mask:0xf
v_and_b32_dpp v87, v34, v7 row_newbcast:5 row_mask:0xf bank_mask:0xf
v_add_f32_dpp v35, v35, v35 row_bcast:15 row_mask:0xa bank_mask:0xf
s_waitcnt vmcnt(17)
v_mfma_f32_16x16x32_bf16 v[240:243], v[80:83], v[144:147], v[240:243]
v_and_b32_dpp v88, v34, v4 row_newbcast:6 row_mask:0xf bank_mask:0xf
v_and_b32_dpp v89, v34, v5 row_newbcast:6 row_mask:0xf bank_mask:0xf
v_and_b32_dpp v90, v34, v6 row_newbcast:6 row_mask:0xf bank_mask:0xf
v_and_b32_dpp v91, v34, v7 row_newbcast:6 row_mask:0xf bank_mask:0xf
v_add_f32_dpp v35, v35, v35 row_bcast:31 row_mask:0xc bank_mask:0xf
s_waitcnt vmcnt(16)
v_mfma_f32_16x16x32_bf16 v[240:243], v[84:87], v[148:151], v[240:243]
v_and_b32_dpp v92, v34, v4 row_newbcast:7 row_mask:0xf bank_mask:0xf
v_and_b32_dpp v93, v34, v5 row_newbcast:7 row_mask:0xf bank_mask:0xf
v_and_b32_dpp v94, v34, v6 row_newbcast:7 row_mask:0xf bank_mask:0xf
v_and_b32_dpp v95, v34, v7 row_newbcast:7 row_mask:0xf bank_mask:0xf
s_waitcnt vmcnt(15)
v_mfma_f32_16x16x32_bf16 v[240:243], v[88:91], v[152:155], v[240:243]
v_and_b32_dpp v96, v34, v4 row_newbcast:8 row_mask:0xf bank_mask:0xf
v_and_b32_dpp v97, v34, v5 row_newbcast:8 row_mask:0xf bank_mask:0xf
v_and_b32_dpp v98, v34, v6 row_newbcast:8 row_mask:0xf bank_mask:0xf
v_and_b32_dpp v99, v34, v7 row_newbcast:8 row_mask:0xf bank_mask:0xf
v_readlane_b32 s12, v35, 63
s_waitcnt vmcnt(14)
v_mfma_f32_16x16x32_bf16 v[240:243], v[92:95], v[156:159], v[240:243]
v_and_b32_dpp v100, v34, v4 row_newbcast:9 row_mask:0xf bank_mask:0xf
v_and_b32_dpp v101, v34, v5 row_newbcast:9 row_mask:0xf bank_mask:0xf
v_and_b32_dpp v102, v34, v6 row_newbcast:9 row_mask:0xf bank_mask:0xf
v_and_b32_dpp v103, v34, v7 row_newbcast:9 row_mask:0xf bank_mask:0xf
s_waitcnt vmcnt(13)
v_mfma_f32_16x16x32_bf16 v[240:243], v[96:99], v[160:163], v[240:243]
v_and_b32_dpp v104, v34, v4 row_newbcast:10 row_mask:0xf bank_mask:0xf
v_and_b32_dpp v105, v34, v5 row_newbcast:10 row_mask:0xf bank_mask:0xf
v_and_b32_dpp v106, v34, v6 row_newbcast:10 row_mask:0xf bank_mask:0xf
v_and_b32_dpp v107, v34, v7 row_newbcast:10 row_mask:0xf bank_mask:0xf
v_mov_b32 v36, s12
s_waitcnt vmcnt(12)
v_mfma_f32_16x16x32_bf16 v[240:243], v[100:103], v[164:167], v[240:243]
v_and_b32_dpp v108, v34, v4 row_newbcast:11 row_mask:0xf bank_mask:0xf
v_and_b32_dpp v109, v34, v5 row_newbcast:11 row_mask:0xf bank_mask:0xf
v_and_b32_dpp v110, v34, v6 row_newbcast:11 row_mask:0xf bank_mask:0xf
v_and_b32_dpp v111, v34, v7 row_newbcast:11 row_mask:0xf bank_mask:0xf
ds_write_b32 v23, v36 offset:528
s_waitcnt vmcnt(11)
v_mfma_f32_16x16x32_bf16 v[240:243], v[104:107], v[168:171], v[240:243]
v_and_b32_dpp v112, v34, v4 row_newbcast:12 row_mask:0xf bank_mask:0xf
v_and_b32_dpp v113, v34, v5 row_newbcast:12 row_mask:0xf bank_mask:0xf
v_and_b32_dpp v114, v34, v6 row_newbcast:12 row_mask:0xf bank_mask:0xf
v_and_b32_dpp v115, v34, v7 row_newbcast:12 row_mask:0xf bank_mask:0xf
s_waitcnt vmcnt(10)
v_mfma_f32_16x16x32_bf16 v[240:243], v[108:111], v[172:175], v[240:243]
v_and_b32_dpp v116, v34, v4 row_newbcast:13 row_mask:0xf bank_mask:0xf
v_and_b32_dpp v117, v34, v5 row_newbcast:13 row_mask:0xf bank_mask:0xf
v_and_b32_dpp v118, v34, v6 row_newbcast:13 row_mask:0xf bank_mask:0xf
v_and_b32_dpp v119, v34, v7 row_newbcast:13 row_mask:0xf bank_mask:0xf
s_waitcnt vmcnt(9)
v_mfma_f32_16x16x32_bf16 v[240:243], v[112:115], v[176:179], v[240:243]
v_and_b32_dpp v120, v34, v4 row_newbcast:14 row_mask:0xf bank_mask:0xf
v_and_b32_dpp v121, v34, v5 row_newbcast:14 row_mask:0xf bank_mask:0xf
v_and_b32_dpp v122, v34, v6 row_newbcast:14 row_mask:0xf bank_mask:0xf
v_and_b32_dpp v123, v34, v7 row_newbcast:14 row_mask:0xf bank_mask:0xf
s_waitcnt vmcnt(8)
v_mfma_f32_16x16x32_bf16 v[240:243], v[116:119], v[180:183], v[240:243]
v_and_b32_dpp v124, v34, v4 row_newbcast:15 row_mask:0xf bank_mask:0xf
v_and_b32_dpp v125, v34, v5 row_newbcast:15 row_mask:0xf bank_mask:0xf
v_and_b32_dpp v126, v34, v6 row_newbcast:15 row_mask:0xf bank_mask:0xf
v_and_b32_dpp v127, v34, v7 row_newbcast:15 row_mask:0xf bank_mask:0xf
s_waitcnt vmcnt(7)
v_mfma_f32_16x16x32_bf16 v[240:243], v[120:123], v[184:187], v[240:243]
s_nop 1
s_waitcnt vmcnt(6)
v_mfma_f32_16x16x32_bf16 v[240:243], v[124:127], v[188:191], v[240:243]
v_and_b32 v24, 1, v3
v_lshlrev_b32 v24, 4, v24
v_lshlrev_b32 v25, 5, v2
v_add_u32 v24, v24, v25
s_lshl_b32 s12, s5, 9
v_add_u32 v24, s12, v24
s_lshl_b32 s13, s5, 5
v_add_u32 v26, s13, v12
ds_write_b128 v24, v[240:243] offset:1024
ds_read_b32 v27, v26 offset:256
ds_read_b32 v28, v26 offset:384
s_lshl_b32 s13, s5, 7
v_add_u32 v26, s13, v12
s_add_u32 s14, s52, 0
s_and_b32 s14, s14, 3
s_lshl_b32 s14, s14, 5
v_add_u32 v44, s14, v26
s_add_u32 s14, s52, 1
s_and_b32 s14, s14, 3
s_lshl_b32 s14, s14, 5
v_add_u32 v45, s14, v26
s_add_u32 s14, s52, 2
s_and_b32 s14, s14, 3
s_lshl_b32 s14, s14, 5
v_add_u32 v46, s14, v26
s_add_u32 s14, s52, 3
s_and_b32 s14, s14, 3
s_lshl_b32 s14, s14, 5
v_add_u32 v47, s14, v26
s_waitcnt lgkmcnt(0)
s_barrier
v_and_b32 v64, v27, v4
v_and_b32 v65, v27, v5
v_and_b32 v66, v27, v6
v_and_b32 v67, v27, v7
v_and_b32 v68, v28, v4
v_and_b32 v69, v28, v5
v_and_b32 v70, v28, v6
v_and_b32 v71, v28, v7
s_waitcnt vmcnt(0)
v_mfma_f32_16x16x32_bf16 v[244:247], v[64:67], v[208:211], 0
v_mfma_f32_16x16x32_bf16 v[244:247], v[68:71], v[212:215], v[244:247]
s_mov_b32 exec_lo, 0x00ff00ff
s_mov_b32 exec_hi, 0xff00ff00
s_nop 6
ds_write_b128 v13, v[244:247] offset:5632
s_mov_b64 exec, -1
s_waitcnt lgkmcnt(0)
s_barrier
ds_read_b32 v40, v44 offset:3072
ds_read_b32 v41, v45 offset:3072
ds_read_b32 v42, v46 offset:3072
ds_read_b32 v43, v47 offset:3072
s_waitcnt lgkmcnt(3)
v_and_b32 v72, v40, v4
v_and_b32 v73, v40, v5
v_and_b32 v74, v40, v6
v_and_b32 v75, v40, v7
s_waitcnt lgkmcnt(2)
v_and_b32 v76, v41, v4
v_and_b32 v77, v41, v5
v_and_b32 v78, v41, v6
v_and_b32 v79, v41, v7
v_mfma_f32_16x16x32_bf16 v[240:243], v[72:75], v[192:195], 0
s_waitcnt lgkmcnt(1)
v_and_b32 v80, v42, v4
v_and_b32 v81, v42, v5
v_and_b32 v82, v42, v6
v_and_b32 v83, v42, v7
v_mfma_f32_16x16x32_bf16 v[240:243], v[76:79], v[196:199], v[240:243]
s_waitcnt lgkmcnt(0)
v_and_b32 v84, v43, v4
v_and_b32 v85, v43, v5
v_and_b32 v86, v43, v6
v_and_b32 v87, v43, v7
v_mfma_f32_16x16x32_bf16 v[240:243], v[80:83], v[200:203], v[240:243]
s_nop 0
v_mfma_f32_16x16x32_bf16 v[240:243], v[84:87], v[204:207], v[240:243]
s_mov_b32 exec_lo, 0x00ff00ff
s_mov_b32 exec_hi, 0xff00ff00
s_nop 5
ds_write_b128 v13, v[240:243] offset:3584
s_waitcnt lgkmcnt(0)
s_barrier
L_fin:
L_end:
s_endpgm
.section .rodata,"a"
.p2align 6
.amdhsa_kernel parallel_sum__sliding_block_cached__dense_activation_silu__decode_kernel
  .amdhsa_next_free_vgpr 256
  .amdhsa_next_free_sgpr 102
  .amdhsa_accum_offset 256
  .amdhsa_group_segment_fixed_size 0
  .amdhsa_kernarg_size 88
  .amdhsa_user_sgpr_count 2
  .amdhsa_user_sgpr_kernarg_segment_ptr 1
  .amdhsa_system_sgpr_workgroup_id_x 1
.end_amdhsa_kernel
```
